```python
import torch

def _softmax(x, axis=-1):
    return torch.softmax(x, dim=axis)

def _gelu(x):
    return torch.nn.functional.gelu(x, approximate='tanh')

def _silu(x):
    return torch.nn.functional.silu(x)

def _sigmoid(x):
    return torch.sigmoid(x)

def _layernorm(x, axis=-1, eps=1e-05):
    m = x.mean(dim=axis, keepdim=True)
    v = x.var(dim=axis, keepdim=True, unbiased=False)
    return (x - m) / torch.sqrt(v + eps)

def _scatter_add(tgt, idx, src, axis=0):
    return tgt.clone().index_add_(axis, idx, src)

def _segment_sum(src, seg, n):
    out = torch.zeros((n,) + src.shape[1:], dtype=src.dtype)
    return out.index_add_(0, seg, src)

def _pad(x, pw):
    flat = tuple((v for pair in reversed(pw) for v in pair))
    return torch.nn.functional.pad(x, flat)
kernel_name = 'gather_scatter__tensor_product_equiv_mace__graph'

def setup_inputs():

    _w = lambda a: (lambda t: t.to(torch.bfloat16) if t.is_floating_point() else t)(torch.as_tensor(a))
    N, deg = (10000, 64)
    Lmax, C, De = (1, 64, 4)
    M = (Lmax + 1) ** 2
    E = N * deg
    src = (lambda lo, hi, *s: torch.randint(lo, hi, s))(0, N, E).to(torch.int64)
    dst = (lambda lo, hi, *s: torch.randint(lo, hi, s))(0, N, E).to(torch.int64)
    r = (lambda *s: torch.randn(*s, dtype=torch.bfloat16) * 0.05)(E, 3).to(float)
    r = r / (torch.linalg.norm(r, dim=-1, keepdim=True).to(float) + 1e-06)
    rx, ry, rz = (r[:, 0].clone(), r[:, 1].clone(), r[:, 2].clone())
    x2, y2, z2 = (rx * rx, ry * ry, rz * rz)
    sh_list = [torch.ones_like(rx), rx, ry, rz, rx * ry, ry * rz, 2.0 * z2 - x2 - y2, rx * rz, x2 - y2, ry * (3.0 * x2 - y2), rx * ry * rz, ry * (4.0 * z2 - x2 - y2), rz * (2.0 * z2 - 3.0 * x2 - 3.0 * y2), rx * (4.0 * z2 - x2 - y2), rz * (x2 - y2), rx * (x2 - 3.0 * y2)]
    sh16 = torch.stack(sh_list, dim=-1).to(float)
    pad = max(0, M - 16)
    sh_full = torch.cat([sh16, torch.zeros((E, pad), dtype=float)], dim=-1)[:, :M]
    cg = ((lambda *s: torch.randn(*s, dtype=torch.bfloat16) * 0.05)(M, M, M) * (1.0 / float(M))).to(float)
    return {'x': _w(((lambda *s: torch.randn(*s, dtype=torch.bfloat16) * 0.05)(N, M, C) * 0.3).to(float)), 'src': _w(src), 'dst': _w(dst), 'sh': _w(sh_full.to(float)), 'edge_attr': _w(((lambda *s: torch.randn(*s, dtype=torch.bfloat16) * 0.05)(E, De) * 0.3).to(float)), 'cg': _w(cg), 'w_r': _w(((lambda *s: torch.randn(*s, dtype=torch.bfloat16) * 0.05)(De, C) * (1.0 / float(De) ** 0.5)).to(float)), 'w_out': _w(((lambda *s: torch.randn(*s, dtype=torch.bfloat16) * 0.05)(C, C) * (1.0 / float(C) ** 0.5)).to(float))}

def reference(x, src, dst, sh, edge_attr, cg, w_r, w_out):
    N = x.shape[0]
    M = x.shape[1]
    C = x.shape[2]
    h = x[src]
    tp = torch.einsum('uvw,euc,ev->ewc', cg, h, sh)
    rw = edge_attr @ w_r
    msg = tp * rw[:, None, :]
    msg2 = msg.reshape(-1, M * C)
    agg = _segment_sum(msg2, dst, N).reshape(N, M, C)
    out = torch.einsum('nmc,cd->nmd', agg, w_out)
    return out
```

```asm
; @launch grid=(256,1,1) block=(1024,1,1) lds=148352
.amdgcn_target "amdgcn-amd-amdhsa--gfx950"
.text
.globl gather_scatter__tensor_product_equiv_mace__graph_kernel
.p2align 8
.type gather_scatter__tensor_product_equiv_mace__graph_kernel,@function
gather_scatter__tensor_product_equiv_mace__graph_kernel:
    s_cmp_ge_u32 s2, 256
    s_cbranch_scc1 L_end
    s_load_dwordx16 s[4:19], s[0:1], 0
    s_load_dwordx4 s[20:23], s[0:1], 64
    s_load_dwordx2 s[24:25], s[0:1], 80
    v_lshrrev_b32 v60, 6, v0
    v_and_b32 v1, 63, v0
    v_readfirstlane_b32 s44, v60
    v_mov_b32 v58, 4
    s_movk_i32 s45, 16
    s_cmp_lt_u32 s44, 10
    s_cbranch_scc1 A_load
H_head:
    v_mov_b64 v[64:65], 0
    v_mov_b64 v[66:67], 0
    v_lshlrev_b32 v60, 4, v1
    s_cmp_gt_u32 s44, 11
    s_cbranch_scc1 H_warm
    ds_write_b128 v60, v[64:67] offset:1024
    ds_write_b128 v64, v[64:67] offset:3072
    s_cmp_eq_u32 s44, 11
    s_waitcnt lgkmcnt(0)
    s_barrier
    s_cbranch_scc1 A_tag
    s_branch A_scan
H_warm:
    s_getpc_b64 s[26:27]
H_pc:
    s_bfe_u32 s52, s2, 0x40003
    s_and_b32 s53, s44, 3
    s_lshl4_add_u32 s52, s53, s52
    s_lshl_b32 s52, s52, 6
    s_load_dword s3, s[26:27], s52
    s_barrier
    s_add_u32 s52, s52, 4096
    s_waitcnt lgkmcnt(0)
    s_load_dword s3, s[26:27], s52
    s_add_u32 s52, s52, 4096
    s_min_u32 s52, s52, L_last-H_pc
    s_load_dword s3, s[26:27], s52
    s_mul_i32 s52, s53, 3797760
    s_add_u32 s52, s52, 54912
    s_mul_i32 s53, s53, 1706664
    s_load_dword s3, s[24:25], s52
    s_add_u32 s52, s52, 1265920
    s_load_dword s3, s[24:25], s52
    s_add_u32 s52, s52, 1265920
    s_load_dword s3, s[24:25], s52
    s_load_dword s3, s[4:5], s53
    s_load_dword s3, s[20:21], s53
    s_branch A_const
A_load:
    s_mul_i32 s26, s2, 9
    s_add_u32 s26, s26, s44
    s_lshl_b32 s26, s26, 10
    s_mul_i32 s27, s2, 784
    s_add_u32 s27, s27, 2359296
    s_cmp_eq_u32 s44, 9
    s_cselect_b32 s26, s27, s26
    s_movk_i32 s27, 512
    s_cselect_b32 s27, 392, s27
    v_lshl_add_u32 v64, v1, 3, s26
    v_add_u32 v65, s27, v64
    v_cmp_gt_u32 vcc, 625, v0
    v_lshlrev_b32 v66, 1, v64
    v_lshlrev_b32 v67, 1, v65
    s_mov_b64 s[48:49], vcc
    s_mov_b64 exec, s[48:49]
    s_waitcnt lgkmcnt(0)
    global_load_dwordx2 v[68:69], v64, s[8:9] nt
    global_load_dwordx2 v[70:71], v65, s[8:9] nt
    s_cmp_lg_u32 s44, 3
    s_cbranch_scc1 A_not9
    s_mov_b32 s53, 14614528
    s_load_dword s67, s[24:25], s53
A_not9:
    s_mov_b32 s54, 429497
    s_cmp_ge_u32 s44, 6
    s_barrier
    s_cbranch_scc1 A_latew
    global_load_dwordx2 v[72:73], v64, s[6:7] nt
    global_load_dwordx2 v[74:75], v65, s[6:7] nt
    global_load_dwordx4 v[76:79], v66, s[10:11] nt
    global_load_dwordx4 v[84:87], v66, s[12:13] nt
    global_load_dwordx4 v[80:83], v67, s[10:11] nt
    global_load_dwordx4 v[88:91], v67, s[12:13] nt
    s_waitcnt vmcnt(6)
    s_branch A_rank
A_latew:
    s_waitcnt vmcnt(0)
A_rank:
    v_mul_u32_u24 v60, s54, v68
    v_lshlrev_b32_sdwa v92, 2, v60 dst_sel:DWORD dst_unused:UNUSED_PAD src0_sel:DWORD src1_sel:BYTE_3
    ds_add_rtn_u32 v96, v92, v58 offset:1024
    v_mul_u32_u24 v60, s54, v69
    v_lshlrev_b32_sdwa v93, 2, v60 dst_sel:DWORD dst_unused:UNUSED_PAD src0_sel:DWORD src1_sel:BYTE_3
    ds_add_rtn_u32 v97, v93, v58 offset:1024
    v_mul_u32_u24 v60, s54, v70
    v_lshlrev_b32_sdwa v94, 2, v60 dst_sel:DWORD dst_unused:UNUSED_PAD src0_sel:DWORD src1_sel:BYTE_3
    ds_add_rtn_u32 v98, v94, v58 offset:1024
    v_mul_u32_u24 v60, s54, v71
    v_lshlrev_b32_sdwa v95, 2, v60 dst_sel:DWORD dst_unused:UNUSED_PAD src0_sel:DWORD src1_sel:BYTE_3
    ds_add_rtn_u32 v99, v95, v58 offset:1024
    s_movk_i32 s55, 625
    s_movk_i32 s56, 584
    s_movk_i32 s57, 1500
    v_mov_b32 v61, 3000
    v_mov_b32 v62, 0
    s_mov_b64 exec, 1
    s_waitcnt lgkmcnt(0)
    ds_add_u32 v62, v58 offset:3076
    s_mov_b64 exec, s[48:49]
    s_cmp_lt_u32 s44, 6
    s_cbranch_scc1 A_both
    global_load_dwordx2 v[72:73], v64, s[6:7] nt
    global_load_dwordx2 v[74:75], v65, s[6:7] nt
    global_load_dwordx4 v[76:79], v66, s[10:11] nt
    global_load_dwordx4 v[84:87], v66, s[12:13] nt
    global_load_dwordx4 v[80:83], v67, s[10:11] nt
    global_load_dwordx4 v[88:91], v67, s[12:13] nt
A_both:
    s_cmp_lg_u32 s44, 3
    s_cbranch_scc1 A_not9b
    s_mul_i32 s67, s67, 0x9E3779B1
    s_add_u32 s67, s67, 0x7F4A7C15
    v_mov_b32 v63, s67
    ds_write_b32 v62, v63 offset:8
A_not9b:
    v_mad_u32_u24 v60, v92, s55, 60
    v_lshrrev_b32 v60, 6, v60
    v_sub_u32 v68, v68, v60
    v_mul_u32_u24 v60, 43, v68
    v_lshrrev_b32 v60, 7, v60
    v_mad_i32_i24 v60, v60, -3, v68
    v_mad_u32_u24 v100, v60, s57, v61
    v_mul_u32_u24 v68, s56, v68
    v_mad_u32_u24 v60, v93, s55, 60
    v_lshrrev_b32 v60, 6, v60
    v_sub_u32 v69, v69, v60
    v_mul_u32_u24 v60, 43, v69
    v_lshrrev_b32 v60, 7, v60
    v_mad_i32_i24 v60, v60, -3, v69
    v_mad_u32_u24 v101, v60, s57, v61
    v_mul_u32_u24 v69, s56, v69
    v_mad_u32_u24 v60, v94, s55, 60
    v_lshrrev_b32 v60, 6, v60
    v_sub_u32 v70, v70, v60
    v_mul_u32_u24 v60, 43, v70
    v_lshrrev_b32 v60, 7, v60
    v_mad_i32_i24 v60, v60, -3, v70
    v_mad_u32_u24 v102, v60, s57, v61
    v_mul_u32_u24 v70, s56, v70
    v_mad_u32_u24 v60, v95, s55, 60
    v_lshrrev_b32 v60, 6, v60
    v_sub_u32 v71, v71, v60
    v_mul_u32_u24 v60, 43, v71
    v_lshrrev_b32 v60, 7, v60
    v_mad_i32_i24 v60, v60, -3, v71
    v_mad_u32_u24 v103, v60, s57, v61
    v_mul_u32_u24 v71, s56, v71
    s_branch W_look1
W_spin1:
    s_sleep 1
W_look1:
    ds_read_b32 v63, v62 offset:3072
    s_waitcnt lgkmcnt(0)
    v_cmp_gt_u32 vcc, 1, v63
    s_cbranch_vccnz W_spin1
    ds_read_b32 v104, v92 offset:2048
    ds_read_b32 v105, v93 offset:2048
    ds_read_b32 v106, v94 offset:2048
    ds_read_b32 v107, v95 offset:2048
    v_mov_b32 v64, 280
    v_mov_b32 v65, 284
    s_mov_b64 exec, -1
    s_add_u32 s65, s44, s2
    s_and_b32 s65, s65, 15
    s_lshl_b32 s65, s65, 6
    v_lshlrev_b32 v114, 4, v1
    v_lshl_add_u32 v113, v1, 3, s65
    ds_read_b32 v120, v113 offset:2048
    ds_read_b32 v122, v113 offset:2052
    s_mul_i32 s40, s2, 55040
    s_add_u32 s40, s24, s40
    s_addc_u32 s41, s25, 0
    s_and_b32 s41, s41, 0xffff
    s_mov_b32 s43, 0x20000
    s_waitcnt lgkmcnt(0)
    v_readlane_b32 s52, v120, 0
    v_readlane_b32 s53, v120, 8
    s_and_b32 s52, s52, 0xffff
    s_and_b32 s53, s53, 0xffff
    s_lshl_b32 s52, s52, 4
    s_lshl_b32 s53, s53, 4
    v_add_u32 v113, s52, v114
    s_sub_u32 s52, s52, 90112
    s_sub_u32 s42, s53, 90112
    v_add_u32 v112, s52, v114
    s_mov_b64 exec, s[48:49]
    s_waitcnt vmcnt(4)
    v_cmp_gt_u32 vcc, v100, v72
    v_lshl_or_b32 v100, v72, 16, v68
    v_mad_u32_u16 v61, v104, s45, v96 op_sel:[1,0,0,0]
    v_cndmask_b32 v60, v64, v65, vcc
    v_add_u32 v100, v100, v60
    ds_write_b32 v61, v100
    v_lshlrev_b32 v96, 2, v96
    v_mad_u32_u16 v92, v104, s45, v96
    v_cmp_gt_u32 vcc, v101, v73
    v_lshl_or_b32 v101, v73, 16, v69
    v_mad_u32_u16 v61, v105, s45, v97 op_sel:[1,0,0,0]
    v_cndmask_b32 v60, v64, v65, vcc
    v_add_u32 v101, v101, v60
    ds_write_b32 v61, v101
    v_lshlrev_b32 v97, 2, v97
    v_mad_u32_u16 v93, v105, s45, v97
    v_cmp_gt_u32 vcc, v102, v74
    v_lshl_or_b32 v102, v74, 16, v70
    v_mad_u32_u16 v61, v106, s45, v98 op_sel:[1,0,0,0]
    v_cndmask_b32 v60, v64, v65, vcc
    v_add_u32 v102, v102, v60
    ds_write_b32 v61, v102
    v_lshlrev_b32 v98, 2, v98
    v_mad_u32_u16 v94, v106, s45, v98
    v_cmp_gt_u32 vcc, v103, v75
    v_lshl_or_b32 v103, v75, 16, v71
    v_mad_u32_u16 v61, v107, s45, v99 op_sel:[1,0,0,0]
    v_cndmask_b32 v60, v64, v65, vcc
    v_add_u32 v103, v103, v60
    ds_write_b32 v61, v103
    v_lshlrev_b32 v99, 2, v99
    v_mad_u32_u16 v95, v107, s45, v99
    s_waitcnt vmcnt(2)
    ds_write2_b64 v92, v[76:77], v[84:85] offset0:0 offset1:1
    ds_write2_b64 v93, v[78:79], v[86:87] offset0:0 offset1:1
    s_waitcnt vmcnt(0)
    ds_write2_b64 v94, v[80:81], v[88:89] offset0:0 offset1:1
    ds_write2_b64 v95, v[82:83], v[90:91] offset0:0 offset1:1
    s_mov_b64 exec, -1
    s_branch A_join2
A_const:
    v_and_b32 v62, 15, v0
    v_bfe_u32 v61, v0, 4, 2
    s_cmp_eq_u32 s44, 13
    s_cbranch_scc1 A_fill
    s_cmp_gt_u32 s44, 13
    s_cbranch_scc1 C_wout
    v_and_b32 v68, 3, v0
    v_bfe_u32 v69, v0, 2, 2
    v_lshlrev_b32 v68, 5, v68
    v_lshl_add_u32 v68, v69, 1, v68
    v_lshlrev_b32 v63, 1, v1
    global_load_ushort v80, v68, s[14:15] offset:0
    global_load_ushort v81, v68, s[14:15] offset:8
    global_load_ushort v82, v68, s[14:15] offset:16
    global_load_ushort v83, v68, s[14:15] offset:24
    global_load_ushort v84, v63, s[16:17] offset:0
    global_load_ushort v85, v63, s[16:17] offset:128
    global_load_ushort v86, v63, s[16:17] offset:256
    global_load_ushort v87, v63, s[16:17] offset:384
    s_branch A_hjoin
C_wout:
    s_sub_u32 s26, s44, 14
    s_lshl_b32 s26, s26, 12
    v_lshlrev_b32 v62, 3, v62
    v_lshl_add_u32 v62, v61, 9, v62
    v_add_u32 v62, s26, v62
    global_load_dwordx2 v[80:81], v62, s[18:19] offset:0
    global_load_dwordx2 v[82:83], v62, s[18:19] offset:128
    global_load_dwordx2 v[84:85], v62, s[18:19] offset:256
    global_load_dwordx2 v[86:87], v62, s[18:19] offset:384
    global_load_dwordx2 v[88:89], v62, s[18:19] offset:2048
    global_load_dwordx2 v[90:91], v62, s[18:19] offset:2176
    global_load_dwordx2 v[92:93], v62, s[18:19] offset:2304
    global_load_dwordx2 v[94:95], v62, s[18:19] offset:2432
    s_branch A_hjoin
A_fill:
    v_mov_b32 v68, 0xffff0000
    v_mov_b32 v69, 0xffff0000
    v_mov_b32 v70, 0xffff0000
    v_mov_b32 v71, 0xffff0000
    ds_write_b128 v60, v[68:71] offset:16384
    ds_write_b128 v60, v[68:71] offset:17408
    ds_write_b128 v60, v[68:71] offset:18432
    ds_write_b128 v60, v[68:71] offset:19456
    ds_write_b128 v60, v[68:71] offset:20480
    ds_write_b128 v60, v[68:71] offset:21504
    ds_write_b128 v60, v[68:71] offset:22528
    ds_write_b128 v60, v[68:71] offset:23552
    ds_write_b128 v60, v[68:71] offset:24576
    ds_write_b128 v60, v[68:71] offset:25600
    ds_write_b128 v60, v[68:71] offset:26624
    ds_write_b128 v60, v[68:71] offset:27648
    ds_write_b128 v60, v[68:71] offset:28672
    ds_write_b128 v60, v[68:71] offset:29696
    ds_write_b128 v60, v[68:71] offset:30720
    ds_write_b128 v60, v[68:71] offset:31744
    ds_write_b128 v60, v[68:71] offset:32768
    ds_write_b128 v60, v[68:71] offset:33792
    ds_write_b128 v60, v[68:71] offset:34816
    ds_write_b128 v60, v[68:71] offset:35840
    ds_write_b128 v60, v[68:71] offset:36864
    ds_write_b128 v60, v[68:71] offset:37888
    ds_write_b128 v60, v[68:71] offset:38912
    s_bfm_b64 exec, 61, 0
    ds_write_b128 v60, v[68:71] offset:39936
    s_bfm_b64 exec, 42, 0
    v_mul_u32_u24 v61, 584, v1
    v_mul_u32_u24 v68, 43, v1
    v_lshrrev_b32 v68, 7, v68
    v_mad_i32_i24 v68, v68, -3, v1
    v_mul_u32_u24 v68, 56, v68
    v_add_u32 v68, 4294967224, v68
    v_sub_u32 v69, 4, v68
    ds_write_b64 v61, v[68:69] offset:16384
    s_mov_b64 exec, 1
    ds_write_b128 v60, v[64:67] offset:40912
    v_mov_b32 v70, 0
    v_mov_b32 v71, 1
    ds_write_b64 v60, v[70:71] offset:0
    s_mov_b64 exec, -1
    s_branch A_hjoin
A_tag:
    s_mov_b32 s32, s24
    s_and_b32 s33, s25, 0xffff
    s_mov_b32 s34, 14614656
    s_mov_b32 s35, 0x20000
    s_and_b32 s68, s2, 15
    s_lshr_b32 s26, s2, 4
    s_lshl4_add_u32 s68, s68, s26
    s_add_u32 s68, s68, 0
    s_lshl_b32 s68, s68, 7
    s_add_u32 s68, s68, 14090240
    v_lshl_add_u32 v62, v1, 15, s68
    s_mov_b64 exec, 0xffff
    buffer_load_dword v59, v62, s[32:35], 0 offen sc1
    s_mov_b64 exec, -1
    s_waitcnt vmcnt(0)
A_hjoin:
    s_branch W_look2
W_spin2:
    s_sleep 1
W_look2:
    ds_read_b32 v63, v64 offset:3072
    s_waitcnt lgkmcnt(0)
    v_cmp_gt_u32 vcc, 1, v63
    s_cbranch_vccnz W_spin2
    s_branch A_join
A_scan:
    v_and_b32 v78, 3, v1
W_spin3:
W_look3:
    ds_read_b32 v63, v64 offset:3076
    s_waitcnt lgkmcnt(0)
    v_cmp_gt_u32 vcc, 40, v63
    s_cbranch_vccnz W_spin3
    ds_read_b128 v[68:71], v60 offset:1024
    v_cmp_eq_u32 vcc, 3, v78
    s_waitcnt lgkmcnt(0)
    v_add_u32 v72, 12, v68
    v_lshrrev_b32 v68, 2, v68
    v_lshrrev_b32 v72, 4, v72
    v_add_u32 v73, 12, v69
    v_lshrrev_b32 v69, 2, v69
    v_lshrrev_b32 v73, 4, v73
    v_add_u32 v74, 12, v70
    v_lshrrev_b32 v70, 2, v70
    v_lshrrev_b32 v74, 4, v74
    v_add_u32 v75, 12, v71
    v_lshrrev_b32 v71, 2, v71
    v_lshrrev_b32 v75, 4, v75
    v_add_u32 v72, v72, v68
    v_add3_u32 v73, v73, v69, v72
    v_add3_u32 v74, v74, v70, v73
    v_add3_u32 v75, v75, v71, v74
    s_nop 1
    v_add_u32_dpp v76, v75, v75 quad_perm:[1,0,3,2] row_mask:0xf bank_mask:0xf
    s_nop 1
    v_add_u32_dpp v76, v76, v76 quad_perm:[2,3,0,1] row_mask:0xf bank_mask:0xf
    v_sub_u32 v76, 0, v76
    v_and_b32 v76, 7, v76
    v_cndmask_b32 v76, 0, v76, vcc
    v_add_u32 v76, v76, v75
    v_sub_u32 v77, 5632, v76
    s_nop 1
    v_add_u32_dpp v76, v76, v76 row_shr:1 row_mask:0xf bank_mask:0xf
    s_nop 1
    v_add_u32_dpp v76, v76, v76 row_shr:2 row_mask:0xf bank_mask:0xf
    s_nop 1
    v_add_u32_dpp v76, v76, v76 row_shr:4 row_mask:0xf bank_mask:0xf
    s_nop 1
    v_add_u32_dpp v76, v76, v76 row_shr:8 row_mask:0xf bank_mask:0xf
    s_nop 1
    v_add_u32_dpp v76, v76, v76 row_bcast:15 row_mask:0xa bank_mask:0xf
    s_nop 1
    v_add_u32_dpp v76, v76, v76 row_bcast:31 row_mask:0xc bank_mask:0xf
    v_add_u32 v80, v76, v77
    v_add_u32 v76, 5632, v76
    v_add_u32 v81, v80, v72
    v_add_u32 v82, v80, v73
    v_add_u32 v83, v80, v74
    v_add_u32 v68, v68, v80
    v_lshl_or_b32 v84, v68, 16, v80
    v_add_u32 v69, v69, v81
    v_lshl_or_b32 v85, v69, 16, v81
    v_add_u32 v70, v70, v82
    v_lshl_or_b32 v86, v70, 16, v82
    v_add_u32 v71, v71, v83
    v_lshl_or_b32 v87, v71, 16, v83
    ds_write_b128 v60, v[84:87] offset:2048
    s_bfm_b64 exec, 1, 63
    s_waitcnt lgkmcnt(0)
    ds_write_b32 v64, v76 offset:3072
    s_mov_b64 exec, -1
A_join:
    s_add_u32 s65, s44, s2
    s_and_b32 s65, s65, 15
    s_lshl_b32 s65, s65, 6
    v_lshlrev_b32 v114, 4, v1
    v_lshl_add_u32 v113, v1, 3, s65
    ds_read_b32 v120, v113 offset:2048
    ds_read_b32 v122, v113 offset:2052
    s_mul_i32 s40, s2, 55040
    s_add_u32 s40, s24, s40
    s_addc_u32 s41, s25, 0
    s_and_b32 s41, s41, 0xffff
    s_mov_b32 s43, 0x20000
    s_waitcnt lgkmcnt(0)
    v_readlane_b32 s52, v120, 0
    v_readlane_b32 s53, v120, 8
    s_and_b32 s52, s52, 0xffff
    s_and_b32 s53, s53, 0xffff
    s_lshl_b32 s52, s52, 4
    s_lshl_b32 s53, s53, 4
    v_add_u32 v113, s52, v114
    s_sub_u32 s52, s52, 90112
    s_sub_u32 s42, s53, 90112
    v_add_u32 v112, s52, v114
A_join2:
    s_waitcnt lgkmcnt(0)
    s_barrier
A_out:
    ds_read_b128 v[64:67], v113 offset:0
    ds_read_b128 v[68:71], v113 offset:1024
    ds_read_b128 v[72:75], v113 offset:2048
    ds_read_b128 v[76:79], v113 offset:3072
    s_waitcnt lgkmcnt(3)
    buffer_store_dwordx4 v[64:67], v112, s[40:43], 0 offen offset:0 sc1
    s_waitcnt lgkmcnt(2)
    buffer_store_dwordx4 v[68:71], v112, s[40:43], 0 offen offset:1024 sc1
    s_waitcnt lgkmcnt(1)
    buffer_store_dwordx4 v[72:75], v112, s[40:43], 0 offen offset:2048 sc1
    s_waitcnt lgkmcnt(0)
    buffer_store_dwordx4 v[76:79], v112, s[40:43], 0 offen offset:3072 sc1
    s_add_u32 s52, s52, 4096
    v_add_u32 v113, 4096, v113
    v_add_u32 v112, 4096, v112
    s_cmp_lt_u32 s52, s42
    s_cbranch_scc1 A_out
    v_mov_b32 v63, 0
    ds_read_b32 v121, v63 offset:8
    v_subrev_u32 v120, 369104384, v120
    v_subrev_u32 v122, 369104384, v122
    s_mov_b32 s32, s24
    s_and_b32 s33, s25, 0xffff
    s_mov_b32 s34, 14614656
    s_mov_b32 s35, 0x20000
    s_sub_u32 s28, s4, 4096
    s_subb_u32 s29, s5, 0
    s_and_b32 s29, s29, 0xffff
    s_mov_b32 s30, 5124096
    s_mov_b32 s31, 0x20000
    s_mov_b32 s36, s20
    s_and_b32 s37, s21, 0xffff
    s_mov_b32 s38, 5120000
    s_mov_b32 s39, 0x20000
    s_and_b32 s47, s2, 7
    s_lshl_b32 s47, s47, 5
    s_lshr_b32 s26, s2, 3
    s_add_u32 s47, s47, s26
    s_movk_i32 s46, 512
    s_mov_b32 s54, 0
    s_mov_b32 s55, 3522560
    s_mov_b32 s56, 7045120
    s_mov_b32 s57, 10567680
    s_mul_i32 s58, s44, 4160
    s_add_u32 s58, s58, 90112
    s_mov_b32 m0, s58
    s_mov_b32 s62, 0
    s_mov_b32 s63, 0
    s_mov_b32 s66, 0
    v_mov_b64 v[4:5], 0
    v_mov_b64 v[6:7], 0
    v_mov_b64 v[8:9], 0
    v_mov_b64 v[10:11], 0
    v_mov_b64 v[12:13], 0
    v_mov_b64 v[14:15], 0
    v_mov_b64 v[16:17], 0
    v_mov_b64 v[18:19], 0
    v_mov_b64 v[20:21], 0
    v_mov_b64 v[22:23], 0
    v_mov_b64 v[24:25], 0
    v_mov_b64 v[26:27], 0
    v_mov_b64 v[28:29], 0
    v_mov_b64 v[30:31], 0
    v_mov_b64 v[32:33], 0
    v_mov_b64 v[34:35], 0
    v_mov_b64 v[36:37], 0
    v_mov_b64 v[38:39], 0
    v_mov_b64 v[40:41], 0
    v_mov_b64 v[42:43], 0
    v_mov_b64 v[44:45], 0
    v_mov_b64 v[46:47], 0
    v_mov_b64 v[48:49], 0
    v_mov_b64 v[50:51], 0
    v_and_b32 v100, 3, v0
    v_bfe_u32 v101, v0, 2, 2
    v_bfe_u32 v102, v0, 4, 2
    v_bfe_u32 v103, v0, 4, 1
    v_lshlrev_b32 v103, 6, v103
    v_and_b32 v52, 15, v0
    v_lshlrev_b32 v52, 4, v52
    v_xor_b32 v52, v52, v103
    v_lshrrev_b32 v104, 1, v101
    v_mul_u32_u24 v104, 2080, v104
    v_and_b32 v105, 1, v101
    v_lshl_add_u32 v104, v105, 7, v104
    v_lshl_add_u32 v104, v102, 8, v104
    v_lshl_add_u32 v104, v100, 3, v104
    v_add3_u32 v53, v104, s58, v103
    v_xor_b32 v103, 64, v103
    v_add3_u32 v54, v104, s58, v103
    v_lshlrev_b32 v55, 2, v102
    v_lshlrev_b32 v56, 1, v100
    s_movk_i32 s58, 4096
    s_movk_i32 s59, 2272
    s_movk_i32 s60, 3072
    s_movk_i32 s61, 1248
    s_lshr_b32 s26, s47, 4
    s_sub_u32 s27, s26, s44
    s_and_b32 s27, s27, 15
    v_and_or_b32 v97, v0, 48, s27
    s_lshl4_add_u32 s26, s26, s27
    s_lshl_b32 s26, s26, 8
    s_and_b32 s27, s47, 15
    s_add_u32 s26, s26, s27
    s_lshl_b32 s26, s26, 3
    s_add_u32 s26, s26, 14090240
    v_bfe_u32 v99, v0, 4, 2
    v_and_b32 v96, 3, v0
    v_lshl_add_u32 v99, v96, 2, v99
    v_lshl_add_u32 v99, v99, 7, s26
    s_mov_b32 s26, 55040
    v_mul_u32_u24 v97, s26, v97
    v_and_b32 v96, 15, v0
    v_add_u32 v96, s62, v96
    v_lshl_add_u32 v98, v96, 2, v97
    s_mov_b32 s72, 0xf000f000
    s_lshl_b32 s65, s65, 2
    s_and_b32 s26, s2, 15
    s_lshr_b32 s27, s2, 4
    s_lshl4_add_u32 s26, s26, s27
    s_add_u32 s26, s26, s65
    s_lshl_b32 s26, s26, 7
    s_add_u32 s26, s26, 14090240
    s_mov_b32 s65, 0
    s_waitcnt lgkmcnt(0)
    v_readfirstlane_b32 s67, v121
    v_mov_b32 v123, v121
    s_mov_b64 exec, 0xff
    s_waitcnt vmcnt(0)
    buffer_store_dwordx4 v[120:123], v114, s[32:35], s26 offen sc1
    s_mov_b64 exec, -1
A_late:
    s_barrier
    s_cmp_lt_u32 s44, 12
    s_cbranch_scc1 B_first
    s_cmp_eq_u32 s44, 13
    s_cbranch_scc1 B_first
    s_cmp_gt_u32 s44, 13
    s_cbranch_scc1 C_w2
    v_lshlrev_b32 v63, 3, v1
    v_and_b32 v68, 15, v0
    v_sub_u32 v68, v68, v55
    v_cmp_gt_u32 vcc, 4, v68
    v_lshlrev_b32 v68, 4, v68
    v_mov_b32 v69, 0x3f80
    v_mov_b32 v67, 0
    v_cndmask_b32 v66, 0, v69, vcc
    v_lshlrev_b64 v[70:71], v68, v[66:67]
    ds_write_b64 v63, v[70:71] offset:3584
    v_lshl_or_b32 v72, v81, 16, v80
    v_lshl_or_b32 v73, v83, 16, v82
    ds_write_b64 v63, v[72:73] offset:512
    v_lshlrev_b32 v76, 16, v84
    v_lshlrev_b32 v77, 16, v85
    v_lshlrev_b32 v78, 16, v86
    v_lshlrev_b32 v79, 16, v87
    ds_write_b128 v114, v[76:79] offset:4096
    s_waitcnt lgkmcnt(0)
    s_branch B_first
C_w2:
    s_sub_u32 s26, s44, 14
    s_lshl_b32 s26, s26, 12
    v_add_u32 v60, s26, v114
    s_mov_b32 s26, 0x05040100
    s_mov_b32 s27, 0x07060302
    v_perm_b32 v64, v82, v80, s26
    v_perm_b32 v65, v86, v84, s26
    v_perm_b32 v66, v90, v88, s26
    v_perm_b32 v67, v94, v92, s26
    ds_write_b128 v60, v[64:67] offset:8192
    v_perm_b32 v68, v82, v80, s27
    v_perm_b32 v69, v86, v84, s27
    v_perm_b32 v70, v90, v88, s27
    v_perm_b32 v71, v94, v92, s27
    ds_write_b128 v60, v[68:71] offset:9216
    v_perm_b32 v72, v83, v81, s26
    v_perm_b32 v73, v87, v85, s26
    v_perm_b32 v74, v91, v89, s26
    v_perm_b32 v75, v95, v93, s26
    ds_write_b128 v60, v[72:75] offset:10240
    v_perm_b32 v76, v83, v81, s27
    v_perm_b32 v77, v87, v85, s27
    v_perm_b32 v78, v91, v89, s27
    v_perm_b32 v79, v95, v93, s27
    ds_write_b128 v60, v[76:79] offset:11264
    s_waitcnt lgkmcnt(0)
B_first:
    s_cmp_lt_u32 s44, 4
    s_cbranch_scc1 B_poll
    s_cmp_lt_u32 s44, 12
    s_cselect_b32 s26, 4, 20
    v_mov_b32 v60, 0
B_chain:
    ds_read_b32 v61, v60 offset:3080
    s_add_u32 s65, s65, 1
    s_cmp_gt_u32 s65, 100
    s_waitcnt lgkmcnt(0)
    s_cbranch_scc1 B_poll
    v_cmp_gt_u32 vcc, s26, v61
    s_cbranch_vccnz B_chain
    s_branch B_poll
B_wait:
    s_sleep 3
B_poll:
    s_mov_b32 exec_lo, 0x000f000f
    s_mov_b32 exec_hi, 0x000f000f
    buffer_load_dwordx2 v[62:63], v99, s[32:35], 0 offen sc1
B_chk:
    s_add_u32 s65, s65, 1
    s_cmp_gt_u32 s65, 0x80000
    s_cbranch_scc1 L_end
    s_waitcnt vmcnt(0)
    v_xor_b32 v63, s67, v63
    v_and_or_b32 v60, v62, s72, v63
    v_cmp_ne_u32 vcc, 0, v60
    s_cbranch_vccnz B_wait
    s_cmp_ge_u32 s44, 8
    s_cbranch_scc1 B_go
    s_mov_b64 exec, 1
    ds_add_u32 v60, v58 offset:3080
B_go:
    s_mov_b64 exec, -1
    s_cmp_lg_u32 s63, 0
    v_mov_b32_dpp v100, v62 row_newbcast:0 row_mask:0xf bank_mask:0xf
    v_mov_b32_dpp v101, v62 row_newbcast:1 row_mask:0xf bank_mask:0xf
    v_mov_b32_dpp v102, v62 row_newbcast:2 row_mask:0xf bank_mask:0xf
    v_mov_b32_dpp v103, v62 row_newbcast:3 row_mask:0xf bank_mask:0xf
    v_add_u32_sdwa v116, v96, v100 dst_sel:DWORD dst_unused:UNUSED_PAD src0_sel:DWORD src1_sel:WORD_0
    v_mad_u32_u16 v104, v100, s45, v98 op_sel:[1,0,0,0]
    v_cmp_lt_u32_sdwa vcc, v116, v100 src0_sel:DWORD src1_sel:WORD_1
    v_lshl_add_u32 v108, v116, 4, v97
    s_cselect_b64 s[4:5], s[4:5], vcc
    v_add_u32_sdwa v117, v96, v101 dst_sel:DWORD dst_unused:UNUSED_PAD src0_sel:DWORD src1_sel:WORD_0
    v_mad_u32_u16 v105, v101, s45, v98 op_sel:[1,0,0,0]
    v_cmp_lt_u32_sdwa vcc, v117, v101 src0_sel:DWORD src1_sel:WORD_1
    v_lshl_add_u32 v109, v117, 4, v97
    s_cselect_b64 s[6:7], s[6:7], vcc
    v_add_u32_sdwa v118, v96, v102 dst_sel:DWORD dst_unused:UNUSED_PAD src0_sel:DWORD src1_sel:WORD_0
    v_mad_u32_u16 v106, v102, s45, v98 op_sel:[1,0,0,0]
    v_cmp_lt_u32_sdwa vcc, v118, v102 src0_sel:DWORD src1_sel:WORD_1
    v_lshl_add_u32 v110, v118, 4, v97
    s_cselect_b64 s[8:9], s[8:9], vcc
    v_add_u32_sdwa v119, v96, v103 dst_sel:DWORD dst_unused:UNUSED_PAD src0_sel:DWORD src1_sel:WORD_0
    v_mad_u32_u16 v107, v103, s45, v98 op_sel:[1,0,0,0]
    v_cmp_lt_u32_sdwa vcc, v119, v103 src0_sel:DWORD src1_sel:WORD_1
    v_lshl_add_u32 v111, v119, 4, v97
    s_cselect_b64 s[10:11], s[10:11], vcc
    s_or_b64 exec, s[4:5], 1
    buffer_load_dword v120, v104, s[32:35], s54 offen sc1
    s_or_b64 exec, s[6:7], 1
    buffer_load_dword v121, v105, s[32:35], s55 offen sc1
    s_or_b64 exec, s[8:9], 1
    buffer_load_dword v122, v106, s[32:35], s56 offen sc1
    s_or_b64 exec, s[10:11], 1
    buffer_load_dword v123, v107, s[32:35], s57 offen sc1
    s_or_b64 exec, s[4:5], 1
    buffer_load_dwordx4 v[64:67], v108, s[32:35], s54 offen sc1
    s_or_b64 exec, s[6:7], 1
    buffer_load_dwordx4 v[68:71], v109, s[32:35], s55 offen sc1
    s_or_b64 exec, s[8:9], 1
    buffer_load_dwordx4 v[72:75], v110, s[32:35], s56 offen sc1
    s_or_b64 exec, s[10:11], 1
    buffer_load_dwordx4 v[76:79], v111, s[32:35], s57 offen sc1
    s_mov_b64 exec, -1
    s_mov_b64 s[50:51], 0
    s_mov_b64 s[48:49], 0
    v_add_u32 v116, 16, v116
    v_cmp_lt_u32_sdwa vcc, v116, v100 src0_sel:DWORD src1_sel:WORD_1
    s_cmp_lg_u32 s63, 0
    s_cselect_b64 s[12:13], s[12:13], vcc
    s_or_b64 s[48:49], s[48:49], vcc
    s_or_b64 s[50:51], s[50:51], s[12:13]
    v_add_u32 v117, 16, v117
    v_cmp_lt_u32_sdwa vcc, v117, v101 src0_sel:DWORD src1_sel:WORD_1
    s_cmp_lg_u32 s63, 0
    s_cselect_b64 s[14:15], s[14:15], vcc
    s_or_b64 s[48:49], s[48:49], vcc
    s_or_b64 s[50:51], s[50:51], s[14:15]
    v_add_u32 v118, 16, v118
    v_cmp_lt_u32_sdwa vcc, v118, v102 src0_sel:DWORD src1_sel:WORD_1
    s_cmp_lg_u32 s63, 0
    s_cselect_b64 s[16:17], s[16:17], vcc
    s_or_b64 s[48:49], s[48:49], vcc
    s_or_b64 s[50:51], s[50:51], s[16:17]
    v_add_u32 v119, 16, v119
    v_cmp_lt_u32_sdwa vcc, v119, v103 src0_sel:DWORD src1_sel:WORD_1
    s_cmp_lg_u32 s63, 0
    s_cselect_b64 s[18:19], s[18:19], vcc
    s_or_b64 s[48:49], s[48:49], vcc
    s_or_b64 s[50:51], s[50:51], s[18:19]
    s_cbranch_scc0 B_noh1
    s_mov_b64 exec, s[12:13]
    s_cbranch_execz B_noh1_0
    buffer_load_dword v124, v104, s[32:35], s54 offen offset:64 sc1
    buffer_load_dwordx4 v[80:83], v108, s[32:35], s54 offen offset:256 sc1
B_noh1_0:
    s_mov_b64 exec, s[14:15]
    s_cbranch_execz B_noh1_1
    buffer_load_dword v125, v105, s[32:35], s55 offen offset:64 sc1
    buffer_load_dwordx4 v[84:87], v109, s[32:35], s55 offen offset:256 sc1
B_noh1_1:
    s_mov_b64 exec, s[16:17]
    s_cbranch_execz B_noh1_2
    buffer_load_dword v126, v106, s[32:35], s56 offen offset:64 sc1
    buffer_load_dwordx4 v[88:91], v110, s[32:35], s56 offen offset:256 sc1
B_noh1_2:
    s_mov_b64 exec, s[18:19]
    s_cbranch_execz B_noh1_3
    buffer_load_dword v127, v107, s[32:35], s57 offen offset:64 sc1
    buffer_load_dwordx4 v[92:95], v111, s[32:35], s57 offen offset:256 sc1
B_noh1_3:
    s_mov_b64 exec, -1
B_noh1:
    s_bcnt1_i32_b64 s72, s[4:5]
    s_bcnt1_i32_b64 s73, s[6:7]
    s_add_u32 s73, s73, s72
    s_bcnt1_i32_b64 s74, s[8:9]
    s_add_u32 s74, s74, s73
    s_bcnt1_i32_b64 s75, s[10:11]
    s_add_u32 s75, s75, s74
    s_bcnt1_i32_b64 s76, s[12:13]
    s_add_u32 s76, s76, s75
    s_bcnt1_i32_b64 s77, s[14:15]
    s_add_u32 s77, s77, s76
    s_bcnt1_i32_b64 s52, s[16:17]
    s_add_u32 s52, s52, s77
    s_bcnt1_i32_b64 s53, s[18:19]
    s_add_u32 s53, s53, s52
    v_mov_b32 v60, s53
    v_mov_b32 v61, 0
    s_mov_b64 exec, 1
    ds_add_rtn_u32 v60, v61, v60 offset:4
    ds_add_u32 v61, v58 offset:3084
    s_mov_b64 exec, -1
    s_and_b32 s48, s48, 0x80008000
    s_and_b32 s49, s49, 0x80008000
    s_or_b32 s64, s48, s49
    v_mbcnt_lo_u32_b32 v112, s4, 0
    v_mbcnt_hi_u32_b32 v112, s5, v112
    v_bfrev_b32 v108, -2
    v_mbcnt_lo_u32_b32 v113, s6, 0
    v_mbcnt_hi_u32_b32 v113, s7, v113
    v_bfrev_b32 v109, -2
    v_mbcnt_lo_u32_b32 v114, s8, 0
    v_mbcnt_hi_u32_b32 v114, s9, v114
    v_bfrev_b32 v110, -2
    v_mbcnt_lo_u32_b32 v115, s10, 0
    v_mbcnt_hi_u32_b32 v115, s11, v115
    v_bfrev_b32 v111, -2
    v_and_b32 v97, 15, v0
    v_bfe_u32 v98, v0, 4, 2
    v_mad_u32_u24 v62, v97, 3, v98
    v_min_u32 v62, 41, v62
    v_mul_u32_u24 v96, 584, v62
    v_mul_u32_u24 v98, 56, v98
    v_add_u32 v98, 4294967236, v98
    v_add_u32 v99, 16668, v96
    s_waitcnt lgkmcnt(0)
    v_readfirstlane_b32 s26, v60
    s_add_u32 s53, s52, s26
    s_add_u32 s52, s77, s26
    s_add_u32 s77, s76, s26
    s_add_u32 s76, s75, s26
    s_add_u32 s75, s74, s26
    s_add_u32 s74, s73, s26
    s_add_u32 s73, s72, s26
    s_mov_b32 s72, s26
    s_mov_b32 s26, 0xffff0000
    s_movk_i32 s27, 272
    v_add_lshl_u32 v112, v112, s72, 4
    v_add_lshl_u32 v113, v113, s73, 4
    v_add_lshl_u32 v114, v114, s74, 4
    v_add_lshl_u32 v115, v115, s75, 4
    v_cmp_gt_u32 vcc, 49152, v112
    s_and_b64 s[48:49], vcc, s[4:5]
    v_cmp_gt_u32 vcc, 49152, v113
    s_and_b64 s[72:73], vcc, s[6:7]
    v_cmp_gt_u32 vcc, 49152, v114
    s_and_b64 s[74:75], vcc, s[8:9]
    v_cmp_gt_u32 vcc, 49152, v115
    s_and_b64 s[20:21], vcc, s[10:11]
    s_waitcnt vmcnt(4)
    s_mov_b64 exec, s[48:49]
    v_and_b32 v104, 0xffff, v120
    ds_add_rtn_u32 v108, v104, v58 offset:16104
    s_mov_b64 exec, s[72:73]
    v_and_b32 v105, 0xffff, v121
    ds_add_rtn_u32 v109, v105, v58 offset:16104
    s_mov_b64 exec, s[74:75]
    v_and_b32 v106, 0xffff, v122
    ds_add_rtn_u32 v110, v106, v58 offset:16104
    s_mov_b64 exec, s[20:21]
    v_and_b32 v107, 0xffff, v123
    ds_add_rtn_u32 v111, v107, v58 offset:16104
    s_mov_b64 exec, -1
    v_bfe_i32 v100, v120, 0, 3
    v_and_or_b32 v120, v120, s26, v112
    v_bfe_i32 v101, v121, 0, 3
    v_and_or_b32 v121, v121, s26, v113
    v_bfe_i32 v102, v122, 0, 3
    v_and_or_b32 v122, v122, s26, v114
    v_bfe_i32 v103, v123, 0, 3
    v_and_or_b32 v123, v123, s26, v115
    s_cmp_eq_u64 s[50:51], 0
    s_cbranch_scc1 B_noh1b
    s_waitcnt vmcnt(0)
    s_cmp_eq_u64 s[12:13], 0
    s_cbranch_scc1 B_noh1b_0
    v_mbcnt_lo_u32_b32 v116, s12, 0
    v_mbcnt_hi_u32_b32 v116, s13, v116
    v_add_lshl_u32 v116, v116, s76, 4
    v_cmp_gt_u32 vcc, 49152, v116
    v_and_b32 v62, 0xffff, v124
    v_bfrev_b32 v63, -2
    s_and_b64 exec, vcc, s[12:13]
    ds_add_rtn_u32 v63, v62, v58 offset:16104
    ds_write_b128 v116, v[80:83] offset:40912
    s_mov_b64 exec, -1
    v_bfe_i32 v60, v124, 0, 3
    v_and_or_b32 v124, v124, s26, v116
    s_waitcnt lgkmcnt(0)
    v_cmp_ge_i32 vcc, 272, v63
    v_xad_u32 v63, v63, v60, v62
    s_mov_b64 exec, vcc
    ds_write_b32 v63, v124 offset:16384
    s_andn2_b64 s[12:13], s[12:13], exec
    s_mov_b64 exec, -1
B_noh1b_0:
    s_cmp_eq_u64 s[14:15], 0
    s_cbranch_scc1 B_noh1b_1
    v_mbcnt_lo_u32_b32 v117, s14, 0
    v_mbcnt_hi_u32_b32 v117, s15, v117
    v_add_lshl_u32 v117, v117, s77, 4
    v_cmp_gt_u32 vcc, 49152, v117
    v_and_b32 v62, 0xffff, v125
    v_bfrev_b32 v63, -2
    s_and_b64 exec, vcc, s[14:15]
    ds_add_rtn_u32 v63, v62, v58 offset:16104
    ds_write_b128 v117, v[84:87] offset:40912
    s_mov_b64 exec, -1
    v_bfe_i32 v60, v125, 0, 3
    v_and_or_b32 v125, v125, s26, v117
    s_waitcnt lgkmcnt(0)
    v_cmp_ge_i32 vcc, 272, v63
    v_xad_u32 v63, v63, v60, v62
    s_mov_b64 exec, vcc
    ds_write_b32 v63, v125 offset:16384
    s_andn2_b64 s[14:15], s[14:15], exec
    s_mov_b64 exec, -1
B_noh1b_1:
    s_cmp_eq_u64 s[16:17], 0
    s_cbranch_scc1 B_noh1b_2
    v_mbcnt_lo_u32_b32 v118, s16, 0
    v_mbcnt_hi_u32_b32 v118, s17, v118
    v_add_lshl_u32 v118, v118, s52, 4
    v_cmp_gt_u32 vcc, 49152, v118
    v_and_b32 v62, 0xffff, v126
    v_bfrev_b32 v63, -2
    s_and_b64 exec, vcc, s[16:17]
    ds_add_rtn_u32 v63, v62, v58 offset:16104
    ds_write_b128 v118, v[88:91] offset:40912
    s_mov_b64 exec, -1
    v_bfe_i32 v60, v126, 0, 3
    v_and_or_b32 v126, v126, s26, v118
    s_waitcnt lgkmcnt(0)
    v_cmp_ge_i32 vcc, 272, v63
    v_xad_u32 v63, v63, v60, v62
    s_mov_b64 exec, vcc
    ds_write_b32 v63, v126 offset:16384
    s_andn2_b64 s[16:17], s[16:17], exec
    s_mov_b64 exec, -1
B_noh1b_2:
    s_cmp_eq_u64 s[18:19], 0
    s_cbranch_scc1 B_noh1b_3
    v_mbcnt_lo_u32_b32 v119, s18, 0
    v_mbcnt_hi_u32_b32 v119, s19, v119
    v_add_lshl_u32 v119, v119, s53, 4
    v_cmp_gt_u32 vcc, 49152, v119
    v_and_b32 v62, 0xffff, v127
    v_bfrev_b32 v63, -2
    s_and_b64 exec, vcc, s[18:19]
    ds_add_rtn_u32 v63, v62, v58 offset:16104
    ds_write_b128 v119, v[92:95] offset:40912
    s_mov_b64 exec, -1
    v_bfe_i32 v60, v127, 0, 3
    v_and_or_b32 v127, v127, s26, v119
    s_waitcnt lgkmcnt(0)
    v_cmp_ge_i32 vcc, 272, v63
    v_xad_u32 v63, v63, v60, v62
    s_mov_b64 exec, vcc
    ds_write_b32 v63, v127 offset:16384
    s_andn2_b64 s[18:19], s[18:19], exec
    s_mov_b64 exec, -1
B_noh1b_3:
B_noh1b:
    s_waitcnt lgkmcnt(0)
    v_cmp_ge_i32 s[48:49], s27, v108
    v_xad_u32 v108, v108, v100, v104
    v_cmp_ge_i32 s[72:73], s27, v109
    v_xad_u32 v109, v109, v101, v105
    v_cmp_ge_i32 s[74:75], s27, v110
    v_xad_u32 v110, v110, v102, v106
    v_cmp_ge_i32 s[20:21], s27, v111
    v_xad_u32 v111, v111, v103, v107
    s_mov_b64 exec, s[48:49]
    ds_write_b32 v108, v120 offset:16384
    s_waitcnt vmcnt(3)
    ds_write_b128 v112, v[64:67] offset:40912
    s_mov_b64 exec, s[72:73]
    ds_write_b32 v109, v121 offset:16384
    s_waitcnt vmcnt(2)
    ds_write_b128 v113, v[68:71] offset:40912
    s_mov_b64 exec, s[74:75]
    ds_write_b32 v110, v122 offset:16384
    s_waitcnt vmcnt(1)
    ds_write_b128 v114, v[72:75] offset:40912
    s_mov_b64 exec, s[20:21]
    ds_write_b32 v111, v123 offset:16384
    s_waitcnt vmcnt(0)
    ds_write_b128 v115, v[76:79] offset:40912
    s_mov_b64 exec, -1
    s_andn2_b64 s[4:5], s[4:5], s[48:49]
    s_andn2_b64 s[6:7], s[6:7], s[72:73]
    s_andn2_b64 s[8:9], s[8:9], s[74:75]
    s_andn2_b64 s[10:11], s[10:11], s[20:21]
    s_or_b64 s[26:27], s[4:5], s[6:7]
    s_or_b64 s[26:27], s[26:27], s[8:9]
    s_or_b64 s[26:27], s[26:27], s[10:11]
    s_or_b64 s[26:27], s[26:27], s[12:13]
    s_or_b64 s[26:27], s[26:27], s[14:15]
    s_or_b64 s[26:27], s[26:27], s[16:17]
    s_or_b64 s[26:27], s[26:27], s[18:19]
    s_or_b32 s63, s26, s27
    s_or_b32 s64, s64, s63
    s_cbranch_scc0 B_nocont
    ds_write_b32 v61, v58 offset:0
B_nocont:
    s_sub_u32 s26, s44, 0
    s_cmp_ge_u32 s26, 4
    s_cbranch_scc1 B_nox
    s_mov_b32 s65, 0
B_xw:
    ds_read_b32 v60, v61 offset:3084
    s_add_u32 s65, s65, 1
    s_cmp_gt_u32 s65, 100
    s_waitcnt lgkmcnt(0)
    s_cbranch_scc1 B_nox
    v_cmp_gt_u32 vcc, 64, v60
    s_cbranch_vccnz B_xw
    s_mul_i32 s68, s2, 4
    s_add_u32 s68, s68, s44
    s_sub_u32 s68, s68, 0
    s_mul_i32 s68, s68, 5120
    s_add_u32 s68, s68, 4096
    v_lshl_add_u32 v60, v1, 7, s68
    s_bfm_b64 exec, 40, 0
    buffer_load_dword v59, v60, s[28:31], 0 offen
    s_mov_b64 exec, -1
B_nox:
    s_setprio 2
    s_waitcnt lgkmcnt(0)
    s_barrier
    ds_read_b64 v[62:63], v96 offset:16384
    ds_read_b32 v61, v61 offset:0
    s_and_b32 s26, s47, 15
    s_cselect_b32 s26, 13, 14
    s_cmp_ge_u32 s44, s26
    s_waitcnt lgkmcnt(0)
    v_readfirstlane_b32 s64, v61
    s_cbranch_scc1 L_idle
    v_min_i32 v63, 276, v63
    v_sub_u32 v99, v99, v63
    v_add_u32 v98, v98, v63
    v_lshrrev_b32 v98, 5, v98
    v_lshl_or_b32 v100, v98, 20, v99
    v_min_i32 v62, 276, v62
    v_readlane_b32 s72, v100, s44
    v_add3_u32 v102, v62, v63, 24
    s_lshr_b32 s73, s72, 20
    s_cbranch_scc0 M_slow
    s_and_b32 s72, s72, 0xfffff
    v_add_u32 v60, s72, v55
    ds_read2_b32 v[62:63], v60 offset0:0 offset1:4
    s_mov_b32 s74, 0
    s_sub_u32 s73, s73, 1
    s_waitcnt lgkmcnt(0)
    v_mad_u32_u16 v64, v62, s46, v52 op_sel:[1,0,0,0]
    v_mad_u32_u16 v65, v63, s46, v52 op_sel:[1,0,0,0]
    v_and_b32 v66, 0xffff, v62
    v_add_u32_sdwa v68, v56, v62 dst_sel:DWORD dst_unused:UNUSED_PAD src0_sel:DWORD src1_sel:WORD_0
    v_and_b32 v67, 0xffff, v63
    v_add_u32_sdwa v69, v56, v63 dst_sel:DWORD dst_unused:UNUSED_PAD src0_sel:DWORD src1_sel:WORD_0
    buffer_load_dwordx4 v64, s[28:31], s58 offen offset:0 lds
    buffer_load_dwordx4 v64, s[28:31], s59 offen offset:2080 lds
    buffer_load_dwordx4 v65, s[28:31], s60 offen offset:1024 lds
    buffer_load_dwordx4 v65, s[28:31], s61 offen offset:3104 lds
    s_setprio 0
    ds_read_b64 v[70:71], v66 offset:40912
    ds_read_b64 v[72:73], v67 offset:40912
    ds_read_u16_d16_hi v74, v68 offset:40920
    ds_read_u16_d16_hi v76, v69 offset:40920
    v_lshlrev_b32 v104, 3, v1
    ds_read_b64 v[2:3], v104 offset:512
    v_lshrrev_b32 v104, 5, v102
    v_sub_u32 v104, v104, v98
    v_lshl_add_u32 v101, v98, 5, v99
    v_lshl_or_b32 v101, v104, 20, v101
    s_cmp_lg_u32 s66, 0
    s_cbranch_scc1 S_have1
    s_add_u32 s69, s44, 0
    s_add_u32 s70, s44, 16
    s_add_u32 s71, s44, 32
    s_cmp_ge_u32 s44, 13
    s_cbranch_scc1 S_have1
    v_cmp_gt_u32 vcc, 13, v97
    v_lshl_or_b32 v105, v102, 4, v97
    v_mov_b32 v103, 0
    s_mov_b64 exec, 0x1111
    v_add_u32 v105, 256, v105
    s_mov_b64 exec, -1
    v_cndmask_b32 v105, 2.0, v105, vcc
    s_nop 1
    v_sub_u32_dpp v107, v105, v105 row_ror:1 row_mask:0xf bank_mask:0xf
    v_alignbit_b32 v103, v103, v107, 31
    v_sub_u32_dpp v106, v105, v105 row_ror:2 row_mask:0xf bank_mask:0xf
    v_alignbit_b32 v103, v103, v106, 31
    v_sub_u32_dpp v107, v105, v105 row_ror:3 row_mask:0xf bank_mask:0xf
    v_alignbit_b32 v103, v103, v107, 31
    v_sub_u32_dpp v106, v105, v105 row_ror:4 row_mask:0xf bank_mask:0xf
    v_alignbit_b32 v103, v103, v106, 31
    v_sub_u32_dpp v107, v105, v105 row_ror:5 row_mask:0xf bank_mask:0xf
    v_alignbit_b32 v103, v103, v107, 31
    v_sub_u32_dpp v106, v105, v105 row_ror:6 row_mask:0xf bank_mask:0xf
    v_alignbit_b32 v103, v103, v106, 31
    v_sub_u32_dpp v107, v105, v105 row_ror:7 row_mask:0xf bank_mask:0xf
    v_alignbit_b32 v103, v103, v107, 31
    v_sub_u32_dpp v106, v105, v105 row_ror:8 row_mask:0xf bank_mask:0xf
    v_alignbit_b32 v103, v103, v106, 31
    v_sub_u32_dpp v107, v105, v105 row_ror:9 row_mask:0xf bank_mask:0xf
    v_alignbit_b32 v103, v103, v107, 31
    v_sub_u32_dpp v106, v105, v105 row_ror:10 row_mask:0xf bank_mask:0xf
    v_alignbit_b32 v103, v103, v106, 31
    v_sub_u32_dpp v107, v105, v105 row_ror:11 row_mask:0xf bank_mask:0xf
    v_alignbit_b32 v103, v103, v107, 31
    v_sub_u32_dpp v106, v105, v105 row_ror:12 row_mask:0xf bank_mask:0xf
    v_alignbit_b32 v103, v103, v106, 31
    v_sub_u32_dpp v107, v105, v105 row_ror:13 row_mask:0xf bank_mask:0xf
    v_alignbit_b32 v103, v103, v107, 31
    v_sub_u32_dpp v106, v105, v105 row_ror:14 row_mask:0xf bank_mask:0xf
    v_alignbit_b32 v103, v103, v106, 31
    v_sub_u32_dpp v107, v105, v105 row_ror:15 row_mask:0xf bank_mask:0xf
    v_alignbit_b32 v103, v103, v107, 31
    v_bcnt_u32_b32 v103, v103, 0
    v_and_or_b32 v103, v0, 48, v103
    s_nop 0
    v_readlane_b32 s26, v103, s44
    s_add_u32 s27, s26, 6
    s_cmp_ge_u32 s27, 13
    s_cselect_b32 s76, 13, 0
    s_sub_u32 s27, s27, s76
    s_add_u32 s26, s26, s27
    s_sub_u32 s26, 50, s26
    s_add_u32 s27, s27, 16
    v_cmp_eq_u32 vcc, s27, v103
    s_ff1_i32_b64 s70, vcc
    v_cmp_eq_u32 vcc, s26, v103
    s_ff1_i32_b64 s71, vcc
S_have1:
    v_mov_b32 v57, 2146451456
    v_readlane_b32 s48, v100, s69
    v_readlane_b32 s49, v100, s70
    v_readlane_b32 s50, v100, s71
    v_readlane_b32 s51, v101, s69
    v_readlane_b32 s52, v101, s70
    v_readlane_b32 s53, v101, s71
    v_writelane_b32 v57, s48, 0
    v_writelane_b32 v57, s49, 1
    v_writelane_b32 v57, s50, 2
    v_writelane_b32 v57, s51, 3
    v_writelane_b32 v57, s52, 4
    v_writelane_b32 v57, s53, 5
M_join:
    s_add_u32 s72, s72, 32
    s_sub_u32 s73, s73, 1
    s_cbranch_scc1 M_pop1
M_back1:
    v_add_u32 v60, s72, v55
    ds_read2_b32 v[62:63], v60 offset0:0 offset1:4
    s_waitcnt lgkmcnt(0)
    v_mfma_f32_4x4x4_16b_bf16 v[94:97], v[2:3], v[70:71], 0
    v_mfma_f32_4x4x4_16b_bf16 v[98:101], v[2:3], v[72:73], 0
    v_mad_u32_u16 v64, v62, s46, v52 op_sel:[1,0,0,0]
    v_mad_u32_u16 v65, v63, s46, v52 op_sel:[1,0,0,0]
    v_and_b32 v66, 0xffff, v62
    v_add_u32_sdwa v68, v56, v62 dst_sel:DWORD dst_unused:UNUSED_PAD src0_sel:DWORD src1_sel:WORD_0
    v_and_b32 v67, 0xffff, v63
    v_add_u32_sdwa v69, v56, v63 dst_sel:DWORD dst_unused:UNUSED_PAD src0_sel:DWORD src1_sel:WORD_0
    v_pk_mul_f32 v[94:95], v[94:95], v[74:75] op_sel_hi:[1,0]
    v_pk_mul_f32 v[96:97], v[96:97], v[74:75] op_sel_hi:[1,0]
    v_pk_mul_f32 v[98:99], v[98:99], v[76:77] op_sel_hi:[1,0]
    v_pk_mul_f32 v[100:101], v[100:101], v[76:77] op_sel_hi:[1,0]
    v_cvt_pk_bf16_f32 v102, v94, v95
    v_cvt_pk_bf16_f32 v103, v96, v97
    v_cvt_pk_bf16_f32 v104, v98, v99
    v_cvt_pk_bf16_f32 v105, v100, v101
M_go:
    s_setprio 1
    s_mov_b32 s77, 0
    s_mul_i32 s52, s47, 625
    s_add_u32 s53, s52, 640
    s_add_u32 s52, s52, 15
    s_lshr_b32 s52, s52, 4
    s_lshr_b32 s53, s53, 4
    v_and_b32 v60, 15, v0
    v_lshlrev_b32 v60, 4, v60
    ds_read_b128 v[106:109], v60 offset:4096
    ds_read_b128 v[110:113], v60 offset:4352
    ds_read_b128 v[114:117], v60 offset:4608
    ds_read_b128 v[118:121], v60 offset:4864
M_phase:
    v_readlane_b32 s76, v57, s77
    s_add_u32 s77, s77, 1
    s_lshr_b32 s76, s76, 20
    s_cbranch_scc0 M_seg0_end
    s_sub_u32 s76, s76, 1
M_seg0:
    s_waitcnt vmcnt(0)
    ds_read_b64_tr_b16 v[78:79], v53 offset:0
    ds_read_b64_tr_b16 v[80:81], v53 offset:1024
    ds_read_b64_tr_b16 v[82:83], v53 offset:32
    ds_read_b64_tr_b16 v[84:85], v53 offset:1056
    ds_read_b64_tr_b16 v[86:87], v54 offset:0
    ds_read_b64_tr_b16 v[88:89], v54 offset:1024
    ds_read_b64_tr_b16 v[90:91], v54 offset:32
    ds_read_b64_tr_b16 v[92:93], v54 offset:1056
    s_cmp_ge_u32 s74, 6
    s_waitcnt lgkmcnt(0)
    s_cbranch_scc1 M_last0
    buffer_load_dwordx4 v64, s[28:31], s58 offen offset:0 lds
    buffer_load_dwordx4 v64, s[28:31], s59 offen offset:2080 lds
    buffer_load_dwordx4 v65, s[28:31], s60 offen offset:1024 lds
    buffer_load_dwordx4 v65, s[28:31], s61 offen offset:3104 lds
    ds_read_b64 v[70:71], v66 offset:40912
    ds_read_b64 v[72:73], v67 offset:40912
    ds_read_u16_d16_hi v74, v68 offset:40920
    ds_read_u16_d16_hi v76, v69 offset:40920
    s_add_u32 s72, s72, 32
    s_sub_u32 s73, s73, 1
    s_cbranch_scc1 M_pop2
M_back2:
    v_add_u32 v60, s72, v55
    ds_read2_b32 v[62:63], v60 offset0:0 offset1:4
    v_mfma_f32_16x16x32_bf16 v[4:7], v[102:105], v[78:81], v[4:7]
    v_mfma_f32_16x16x32_bf16 v[8:11], v[102:105], v[82:85], v[8:11]
    v_mfma_f32_16x16x32_bf16 v[12:15], v[102:105], v[86:89], v[12:15]
    v_mfma_f32_16x16x32_bf16 v[16:19], v[102:105], v[90:93], v[16:19]
    s_waitcnt lgkmcnt(0)
    v_mfma_f32_4x4x4_16b_bf16 v[94:97], v[2:3], v[70:71], 0
    v_mfma_f32_4x4x4_16b_bf16 v[98:101], v[2:3], v[72:73], 0
    v_mad_u32_u16 v64, v62, s46, v52 op_sel:[1,0,0,0]
    v_mad_u32_u16 v65, v63, s46, v52 op_sel:[1,0,0,0]
    v_and_b32 v66, 0xffff, v62
    v_add_u32_sdwa v68, v56, v62 dst_sel:DWORD dst_unused:UNUSED_PAD src0_sel:DWORD src1_sel:WORD_0
    v_and_b32 v67, 0xffff, v63
    v_add_u32_sdwa v69, v56, v63 dst_sel:DWORD dst_unused:UNUSED_PAD src0_sel:DWORD src1_sel:WORD_0
    v_pk_mul_f32 v[94:95], v[94:95], v[74:75] op_sel_hi:[1,0]
    v_pk_mul_f32 v[96:97], v[96:97], v[74:75] op_sel_hi:[1,0]
    v_pk_mul_f32 v[98:99], v[98:99], v[76:77] op_sel_hi:[1,0]
    v_pk_mul_f32 v[100:101], v[100:101], v[76:77] op_sel_hi:[1,0]
    v_cvt_pk_bf16_f32 v102, v94, v95
    v_cvt_pk_bf16_f32 v103, v96, v97
    v_cvt_pk_bf16_f32 v104, v98, v99
    v_cvt_pk_bf16_f32 v105, v100, v101
    s_sub_u32 s76, s76, 1
    s_cbranch_scc0 M_seg0
M_seg0_end:
    s_cmp_lt_u32 s77, 4
    s_cbranch_scc1 E_skip0
    s_cmp_lg_u32 s64, 0
    s_cbranch_scc1 E_skip0
    s_waitcnt lgkmcnt(0)
    v_lshlrev_b32 v60, 4, v1
    s_nop 0
    v_pk_mul_f32 v[4:5], v[4:5], v[106:107]
    v_pk_mul_f32 v[8:9], v[8:9], v[110:111]
    v_pk_mul_f32 v[12:13], v[12:13], v[114:115]
    v_pk_mul_f32 v[16:17], v[16:17], v[118:119]
    v_pk_fma_f32 v[4:5], v[6:7], v[108:109], v[4:5]
    v_pk_fma_f32 v[8:9], v[10:11], v[112:113], v[8:9]
    v_pk_fma_f32 v[12:13], v[14:15], v[116:117], v[12:13]
    v_pk_fma_f32 v[16:17], v[18:19], v[120:121], v[16:17]
    v_add_f32 v122, v4, v5
    v_add_f32 v123, v8, v9
    v_add_f32 v124, v12, v13
    v_add_f32 v125, v16, v17
E_skip0:
    v_readlane_b32 s76, v57, s77
    s_add_u32 s77, s77, 1
    s_lshr_b32 s76, s76, 20
    s_cbranch_scc0 M_seg1_end
    s_sub_u32 s76, s76, 1
M_seg1:
    s_waitcnt vmcnt(0)
    ds_read_b64_tr_b16 v[78:79], v53 offset:0
    ds_read_b64_tr_b16 v[80:81], v53 offset:1024
    ds_read_b64_tr_b16 v[82:83], v53 offset:32
    ds_read_b64_tr_b16 v[84:85], v53 offset:1056
    ds_read_b64_tr_b16 v[86:87], v54 offset:0
    ds_read_b64_tr_b16 v[88:89], v54 offset:1024
    ds_read_b64_tr_b16 v[90:91], v54 offset:32
    ds_read_b64_tr_b16 v[92:93], v54 offset:1056
    s_cmp_ge_u32 s74, 6
    s_waitcnt lgkmcnt(0)
    s_cbranch_scc1 M_last1
    buffer_load_dwordx4 v64, s[28:31], s58 offen offset:0 lds
    buffer_load_dwordx4 v64, s[28:31], s59 offen offset:2080 lds
    buffer_load_dwordx4 v65, s[28:31], s60 offen offset:1024 lds
    buffer_load_dwordx4 v65, s[28:31], s61 offen offset:3104 lds
    ds_read_b64 v[70:71], v66 offset:40912
    ds_read_b64 v[72:73], v67 offset:40912
    ds_read_u16_d16_hi v74, v68 offset:40920
    ds_read_u16_d16_hi v76, v69 offset:40920
    s_add_u32 s72, s72, 32
    s_sub_u32 s73, s73, 1
    s_cbranch_scc1 M_pop3
M_back3:
    v_add_u32 v60, s72, v55
    ds_read2_b32 v[62:63], v60 offset0:0 offset1:4
    v_mfma_f32_16x16x32_bf16 v[20:23], v[102:105], v[78:81], v[20:23]
    v_mfma_f32_16x16x32_bf16 v[24:27], v[102:105], v[82:85], v[24:27]
    v_mfma_f32_16x16x32_bf16 v[28:31], v[102:105], v[86:89], v[28:31]
    v_mfma_f32_16x16x32_bf16 v[32:35], v[102:105], v[90:93], v[32:35]
    s_waitcnt lgkmcnt(0)
    v_mfma_f32_4x4x4_16b_bf16 v[94:97], v[2:3], v[70:71], 0
    v_mfma_f32_4x4x4_16b_bf16 v[98:101], v[2:3], v[72:73], 0
    v_mad_u32_u16 v64, v62, s46, v52 op_sel:[1,0,0,0]
    v_mad_u32_u16 v65, v63, s46, v52 op_sel:[1,0,0,0]
    v_and_b32 v66, 0xffff, v62
    v_add_u32_sdwa v68, v56, v62 dst_sel:DWORD dst_unused:UNUSED_PAD src0_sel:DWORD src1_sel:WORD_0
    v_and_b32 v67, 0xffff, v63
    v_add_u32_sdwa v69, v56, v63 dst_sel:DWORD dst_unused:UNUSED_PAD src0_sel:DWORD src1_sel:WORD_0
    v_pk_mul_f32 v[94:95], v[94:95], v[74:75] op_sel_hi:[1,0]
    v_pk_mul_f32 v[96:97], v[96:97], v[74:75] op_sel_hi:[1,0]
    v_pk_mul_f32 v[98:99], v[98:99], v[76:77] op_sel_hi:[1,0]
    v_pk_mul_f32 v[100:101], v[100:101], v[76:77] op_sel_hi:[1,0]
    v_cvt_pk_bf16_f32 v102, v94, v95
    v_cvt_pk_bf16_f32 v103, v96, v97
    v_cvt_pk_bf16_f32 v104, v98, v99
    v_cvt_pk_bf16_f32 v105, v100, v101
    s_sub_u32 s76, s76, 1
    s_cbranch_scc0 M_seg1
M_seg1_end:
    s_cmp_lt_u32 s77, 4
    s_cbranch_scc1 E_skip1
    s_cmp_lg_u32 s64, 0
    s_cbranch_scc1 E_skip1
    s_waitcnt lgkmcnt(0)
    v_lshlrev_b32 v60, 4, v1
    s_nop 0
    v_pk_mul_f32 v[20:21], v[20:21], v[106:107]
    v_pk_mul_f32 v[24:25], v[24:25], v[110:111]
    v_pk_mul_f32 v[28:29], v[28:29], v[114:115]
    v_pk_mul_f32 v[32:33], v[32:33], v[118:119]
    v_pk_fma_f32 v[20:21], v[22:23], v[108:109], v[20:21]
    v_pk_fma_f32 v[24:25], v[26:27], v[112:113], v[24:25]
    v_pk_fma_f32 v[28:29], v[30:31], v[116:117], v[28:29]
    v_pk_fma_f32 v[32:33], v[34:35], v[120:121], v[32:33]
    v_add_f32 v20, v20, v21
    v_add_f32 v24, v24, v25
    v_add_f32 v28, v28, v29
    v_add_f32 v32, v32, v33
    v_cvt_pk_bf16_f32 v122, v122, v20
    v_cvt_pk_bf16_f32 v123, v123, v24
    v_cvt_pk_bf16_f32 v124, v124, v28
    v_cvt_pk_bf16_f32 v125, v125, v32
    ds_read_b128 v[4:7], v60 offset:8192
    ds_read_b128 v[8:11], v60 offset:9216
    ds_read_b128 v[12:15], v60 offset:10240
    ds_read_b128 v[16:19], v60 offset:11264
    ds_read_b128 v[20:23], v60 offset:12288
    ds_read_b128 v[24:27], v60 offset:13312
    ds_read_b128 v[28:31], v60 offset:14336
    ds_read_b128 v[32:35], v60 offset:15360
    v_lshlrev_b32 v60, 3, v1
    ds_read_b64 v[126:127], v60 offset:3584
E_skip1:
    v_readlane_b32 s76, v57, s77
    s_add_u32 s77, s77, 1
    s_lshr_b32 s76, s76, 20
    s_cbranch_scc0 M_seg2_end
    s_sub_u32 s76, s76, 1
M_seg2:
    s_waitcnt vmcnt(0)
    ds_read_b64_tr_b16 v[78:79], v53 offset:0
    ds_read_b64_tr_b16 v[80:81], v53 offset:1024
    ds_read_b64_tr_b16 v[82:83], v53 offset:32
    ds_read_b64_tr_b16 v[84:85], v53 offset:1056
    ds_read_b64_tr_b16 v[86:87], v54 offset:0
    ds_read_b64_tr_b16 v[88:89], v54 offset:1024
    ds_read_b64_tr_b16 v[90:91], v54 offset:32
    ds_read_b64_tr_b16 v[92:93], v54 offset:1056
    s_cmp_ge_u32 s74, 6
    s_waitcnt lgkmcnt(0)
    s_cbranch_scc1 M_last2
    buffer_load_dwordx4 v64, s[28:31], s58 offen offset:0 lds
    buffer_load_dwordx4 v64, s[28:31], s59 offen offset:2080 lds
    buffer_load_dwordx4 v65, s[28:31], s60 offen offset:1024 lds
    buffer_load_dwordx4 v65, s[28:31], s61 offen offset:3104 lds
    ds_read_b64 v[70:71], v66 offset:40912
    ds_read_b64 v[72:73], v67 offset:40912
    ds_read_u16_d16_hi v74, v68 offset:40920
    ds_read_u16_d16_hi v76, v69 offset:40920
    s_add_u32 s72, s72, 32
    s_sub_u32 s73, s73, 1
    s_cbranch_scc1 M_pop4
M_back4:
    v_add_u32 v60, s72, v55
    ds_read2_b32 v[62:63], v60 offset0:0 offset1:4
    v_mfma_f32_16x16x32_bf16 v[36:39], v[102:105], v[78:81], v[36:39]
    v_mfma_f32_16x16x32_bf16 v[40:43], v[102:105], v[82:85], v[40:43]
    v_mfma_f32_16x16x32_bf16 v[44:47], v[102:105], v[86:89], v[44:47]
    v_mfma_f32_16x16x32_bf16 v[48:51], v[102:105], v[90:93], v[48:51]
    s_waitcnt lgkmcnt(0)
    v_mfma_f32_4x4x4_16b_bf16 v[94:97], v[2:3], v[70:71], 0
    v_mfma_f32_4x4x4_16b_bf16 v[98:101], v[2:3], v[72:73], 0
    v_mad_u32_u16 v64, v62, s46, v52 op_sel:[1,0,0,0]
    v_mad_u32_u16 v65, v63, s46, v52 op_sel:[1,0,0,0]
    v_and_b32 v66, 0xffff, v62
    v_add_u32_sdwa v68, v56, v62 dst_sel:DWORD dst_unused:UNUSED_PAD src0_sel:DWORD src1_sel:WORD_0
    v_and_b32 v67, 0xffff, v63
    v_add_u32_sdwa v69, v56, v63 dst_sel:DWORD dst_unused:UNUSED_PAD src0_sel:DWORD src1_sel:WORD_0
    v_pk_mul_f32 v[94:95], v[94:95], v[74:75] op_sel_hi:[1,0]
    v_pk_mul_f32 v[96:97], v[96:97], v[74:75] op_sel_hi:[1,0]
    v_pk_mul_f32 v[98:99], v[98:99], v[76:77] op_sel_hi:[1,0]
    v_pk_mul_f32 v[100:101], v[100:101], v[76:77] op_sel_hi:[1,0]
    v_cvt_pk_bf16_f32 v102, v94, v95
    v_cvt_pk_bf16_f32 v103, v96, v97
    v_cvt_pk_bf16_f32 v104, v98, v99
    v_cvt_pk_bf16_f32 v105, v100, v101
    s_sub_u32 s76, s76, 1
    s_cbranch_scc0 M_seg2
M_seg2_end:
    s_cmp_lt_u32 s77, 4
    s_cbranch_scc1 E_skip2
    s_cmp_lg_u32 s64, 0
    s_cbranch_scc1 E_skip2
    s_waitcnt lgkmcnt(0)
    v_lshlrev_b32 v60, 3, v1
    v_mov_b32 v94, v122
    v_mov_b32 v96, v123
    v_pk_mul_f32 v[36:37], v[36:37], v[106:107]
    v_pk_mul_f32 v[40:41], v[40:41], v[110:111]
    v_pk_fma_f32 v[36:37], v[38:39], v[108:109], v[36:37]
    v_pk_fma_f32 v[40:41], v[42:43], v[112:113], v[40:41]
    v_add_f32 v36, v36, v37
    v_add_f32 v40, v40, v41
    v_cvt_pk_bf16_f32 v95, v36, 0
    v_cvt_pk_bf16_f32 v97, v40, 0
    v_mov_b32 v98, v124
    v_mov_b32 v100, v125
    v_mfma_f32_16x16x16_bf16 v[36:39], v[94:95], v[126:127], 0
    v_mfma_f32_16x16x16_bf16 v[40:43], v[96:97], v[126:127], 0
    v_pk_mul_f32 v[44:45], v[44:45], v[114:115]
    v_pk_mul_f32 v[48:49], v[48:49], v[118:119]
    v_pk_fma_f32 v[44:45], v[46:47], v[116:117], v[44:45]
    v_pk_fma_f32 v[48:49], v[50:51], v[120:121], v[48:49]
    v_add_f32 v44, v44, v45
    v_add_f32 v48, v48, v49
    v_cvt_pk_bf16_f32 v99, v44, 0
    v_cvt_pk_bf16_f32 v101, v48, 0
    v_cvt_pk_bf16_f32 v70, v36, v37
    v_cvt_pk_bf16_f32 v71, v38, v39
    v_mfma_f32_16x16x16_bf16 v[44:47], v[98:99], v[126:127], 0
    v_mfma_f32_16x16x16_bf16 v[48:51], v[100:101], v[126:127], 0
    v_cvt_pk_bf16_f32 v72, v40, v41
    v_cvt_pk_bf16_f32 v73, v42, v43
    s_and_b32 s48, s69, 15
    s_and_b32 s49, s70, 15
    s_and_b32 s50, s71, 15
    v_mfma_f32_16x16x32_bf16 v[78:81], v[70:73], v[4:7], 0
    v_mfma_f32_16x16x32_bf16 v[82:85], v[70:73], v[8:11], 0
    v_mfma_f32_16x16x32_bf16 v[86:89], v[70:73], v[12:15], 0
    v_cvt_pk_bf16_f32 v74, v44, v45
    v_cvt_pk_bf16_f32 v75, v46, v47
    v_cvt_pk_bf16_f32 v76, v48, v49
    v_cvt_pk_bf16_f32 v77, v50, v51
    v_mfma_f32_16x16x32_bf16 v[90:93], v[70:73], v[16:19], 0
    s_mul_i32 s48, s48, 3
    v_mfma_f32_16x16x32_bf16 v[78:81], v[74:77], v[20:23], v[78:81]
    v_mfma_f32_16x16x32_bf16 v[82:85], v[74:77], v[24:27], v[82:85]
    v_mfma_f32_16x16x32_bf16 v[86:89], v[74:77], v[28:31], v[86:89]
    v_mfma_f32_16x16x32_bf16 v[90:93], v[74:77], v[32:35], v[90:93]
    s_mul_i32 s49, s49, 3
    s_mul_i32 s50, s50, 3
    s_add_u32 s48, s48, s52
    s_add_u32 s49, s49, s52
    s_add_u32 s50, s50, s52
    s_add_u32 s49, s49, 1
    s_add_u32 s50, s50, 2
    s_cmp_ge_u32 s48, s53
    s_cbranch_scc1 E_skip2
    v_cvt_pk_bf16_f32 v36, v78, v82
    s_lshl_b32 s48, s48, 9
    v_cvt_pk_bf16_f32 v37, v86, v90
    buffer_store_dwordx2 v[36:37], v60, s[36:39], s48 offen nt
    s_cmp_ge_u32 s49, s53
    s_cbranch_scc1 E_skip2
    v_cvt_pk_bf16_f32 v38, v79, v83
    s_lshl_b32 s49, s49, 9
    v_cvt_pk_bf16_f32 v39, v87, v91
    buffer_store_dwordx2 v[38:39], v60, s[36:39], s49 offen nt
    s_cmp_ge_u32 s50, s53
    s_cbranch_scc1 E_skip2
    v_cvt_pk_bf16_f32 v40, v80, v84
    s_lshl_b32 s50, s50, 9
    v_cvt_pk_bf16_f32 v41, v88, v92
    buffer_store_dwordx2 v[40:41], v60, s[36:39], s50 offen nt
E_skip2:
    s_cmp_lt_u32 s77, 6
    s_cbranch_scc1 M_phase
L_done:
    s_cmp_lg_u32 s64, 0
    s_cbranch_scc1 L_again
L_end:
    s_endpgm
M_pop1:
    s_add_u32 s74, s74, 1
    v_readlane_b32 s72, v57, s74
    s_lshr_b32 s73, s72, 20
    s_cbranch_scc0 M_pop1
    s_sub_u32 s73, s73, 1
    s_and_b32 s72, s72, 0xfffff
    s_branch M_back1
M_pop2:
    s_add_u32 s74, s74, 1
    v_readlane_b32 s72, v57, s74
    s_lshr_b32 s73, s72, 20
    s_cbranch_scc0 M_pop2
    s_sub_u32 s73, s73, 1
    s_and_b32 s72, s72, 0xfffff
    s_branch M_back2
M_pop3:
    s_add_u32 s74, s74, 1
    v_readlane_b32 s72, v57, s74
    s_lshr_b32 s73, s72, 20
    s_cbranch_scc0 M_pop3
    s_sub_u32 s73, s73, 1
    s_and_b32 s72, s72, 0xfffff
    s_branch M_back3
M_pop4:
    s_add_u32 s74, s74, 1
    v_readlane_b32 s72, v57, s74
    s_lshr_b32 s73, s72, 20
    s_cbranch_scc0 M_pop4
    s_sub_u32 s73, s73, 1
    s_and_b32 s72, s72, 0xfffff
    s_branch M_back4
M_last0:
    s_setprio 0
    v_mfma_f32_16x16x32_bf16 v[4:7], v[102:105], v[78:81], v[4:7]
    v_mfma_f32_16x16x32_bf16 v[8:11], v[102:105], v[82:85], v[8:11]
    v_mfma_f32_16x16x32_bf16 v[12:15], v[102:105], v[86:89], v[12:15]
    v_mfma_f32_16x16x32_bf16 v[16:19], v[102:105], v[90:93], v[16:19]
    s_branch M_seg0_end
M_last1:
    s_setprio 0
    v_mfma_f32_16x16x32_bf16 v[20:23], v[102:105], v[78:81], v[20:23]
    v_mfma_f32_16x16x32_bf16 v[24:27], v[102:105], v[82:85], v[24:27]
    v_mfma_f32_16x16x32_bf16 v[28:31], v[102:105], v[86:89], v[28:31]
    v_mfma_f32_16x16x32_bf16 v[32:35], v[102:105], v[90:93], v[32:35]
    s_branch M_seg1_end
M_last2:
    s_setprio 0
    v_mfma_f32_16x16x32_bf16 v[36:39], v[102:105], v[78:81], v[36:39]
    v_mfma_f32_16x16x32_bf16 v[40:43], v[102:105], v[82:85], v[40:43]
    v_mfma_f32_16x16x32_bf16 v[44:47], v[102:105], v[86:89], v[44:47]
    v_mfma_f32_16x16x32_bf16 v[48:51], v[102:105], v[90:93], v[48:51]
    s_branch M_seg2_end
L_idle:
    s_setprio 0
    s_cmp_lg_u32 s2, 0
    s_cbranch_scc1 L_done
    s_cmp_lg_u32 s44, 15
    s_cbranch_scc1 L_done
    v_mov_b32 v78, s67
    s_mov_b32 s26, 14614528
    s_mov_b64 exec, 1
    buffer_store_dword v78, off, s[32:35], s26 sc1
    s_mov_b64 exec, -1
    s_branch L_done
M_slow:
    s_setprio 0
    v_lshlrev_b32 v104, 3, v1
    ds_read_b64 v[2:3], v104 offset:512
    v_lshrrev_b32 v104, 5, v102
    v_sub_u32 v104, v104, v98
    v_lshl_add_u32 v101, v98, 5, v99
    v_lshl_or_b32 v101, v104, 20, v101
    s_cmp_lg_u32 s66, 0
    s_cbranch_scc1 S_have2
    s_add_u32 s69, s44, 0
    s_add_u32 s70, s44, 16
    s_add_u32 s71, s44, 32
    s_cmp_ge_u32 s44, 13
    s_cbranch_scc1 S_have2
    v_cmp_gt_u32 vcc, 13, v97
    v_lshl_or_b32 v105, v102, 4, v97
    v_mov_b32 v103, 0
    s_mov_b64 exec, 0x1111
    v_add_u32 v105, 256, v105
    s_mov_b64 exec, -1
    v_cndmask_b32 v105, 2.0, v105, vcc
    s_nop 1
    v_sub_u32_dpp v107, v105, v105 row_ror:1 row_mask:0xf bank_mask:0xf
    v_alignbit_b32 v103, v103, v107, 31
    v_sub_u32_dpp v106, v105, v105 row_ror:2 row_mask:0xf bank_mask:0xf
    v_alignbit_b32 v103, v103, v106, 31
    v_sub_u32_dpp v107, v105, v105 row_ror:3 row_mask:0xf bank_mask:0xf
    v_alignbit_b32 v103, v103, v107, 31
    v_sub_u32_dpp v106, v105, v105 row_ror:4 row_mask:0xf bank_mask:0xf
    v_alignbit_b32 v103, v103, v106, 31
    v_sub_u32_dpp v107, v105, v105 row_ror:5 row_mask:0xf bank_mask:0xf
    v_alignbit_b32 v103, v103, v107, 31
    v_sub_u32_dpp v106, v105, v105 row_ror:6 row_mask:0xf bank_mask:0xf
    v_alignbit_b32 v103, v103, v106, 31
    v_sub_u32_dpp v107, v105, v105 row_ror:7 row_mask:0xf bank_mask:0xf
    v_alignbit_b32 v103, v103, v107, 31
    v_sub_u32_dpp v106, v105, v105 row_ror:8 row_mask:0xf bank_mask:0xf
    v_alignbit_b32 v103, v103, v106, 31
    v_sub_u32_dpp v107, v105, v105 row_ror:9 row_mask:0xf bank_mask:0xf
    v_alignbit_b32 v103, v103, v107, 31
    v_sub_u32_dpp v106, v105, v105 row_ror:10 row_mask:0xf bank_mask:0xf
    v_alignbit_b32 v103, v103, v106, 31
    v_sub_u32_dpp v107, v105, v105 row_ror:11 row_mask:0xf bank_mask:0xf
    v_alignbit_b32 v103, v103, v107, 31
    v_sub_u32_dpp v106, v105, v105 row_ror:12 row_mask:0xf bank_mask:0xf
    v_alignbit_b32 v103, v103, v106, 31
    v_sub_u32_dpp v107, v105, v105 row_ror:13 row_mask:0xf bank_mask:0xf
    v_alignbit_b32 v103, v103, v107, 31
    v_sub_u32_dpp v106, v105, v105 row_ror:14 row_mask:0xf bank_mask:0xf
    v_alignbit_b32 v103, v103, v106, 31
    v_sub_u32_dpp v107, v105, v105 row_ror:15 row_mask:0xf bank_mask:0xf
    v_alignbit_b32 v103, v103, v107, 31
    v_bcnt_u32_b32 v103, v103, 0
    v_and_or_b32 v103, v0, 48, v103
    s_nop 0
    v_readlane_b32 s26, v103, s44
    s_add_u32 s27, s26, 6
    s_cmp_ge_u32 s27, 13
    s_cselect_b32 s76, 13, 0
    s_sub_u32 s27, s27, s76
    s_add_u32 s26, s26, s27
    s_sub_u32 s26, 50, s26
    s_add_u32 s27, s27, 16
    v_cmp_eq_u32 vcc, s27, v103
    s_ff1_i32_b64 s70, vcc
    v_cmp_eq_u32 vcc, s26, v103
    s_ff1_i32_b64 s71, vcc
S_have2:
    v_mov_b32 v57, 2146451456
    v_readlane_b32 s48, v100, s69
    v_readlane_b32 s49, v100, s70
    v_readlane_b32 s50, v100, s71
    v_readlane_b32 s51, v101, s69
    v_readlane_b32 s52, v101, s70
    v_readlane_b32 s53, v101, s71
    v_writelane_b32 v57, s48, 0
    v_writelane_b32 v57, s49, 1
    v_writelane_b32 v57, s50, 2
    v_writelane_b32 v57, s51, 3
    v_writelane_b32 v57, s52, 4
    v_writelane_b32 v57, s53, 5
    s_mov_b32 s74, 0
M_pop0:
    s_add_u32 s74, s74, 1
    v_readlane_b32 s72, v57, s74
    s_lshr_b32 s73, s72, 20
    s_cbranch_scc0 M_pop0
    s_sub_u32 s73, s73, 1
    s_and_b32 s72, s72, 0xfffff
    s_cmp_ge_u32 s74, 6
    s_cbranch_scc1 M_go
    v_add_u32 v60, s72, v55
    ds_read2_b32 v[62:63], v60 offset0:0 offset1:4
    s_waitcnt lgkmcnt(0)
    v_mad_u32_u16 v64, v62, s46, v52 op_sel:[1,0,0,0]
    v_mad_u32_u16 v65, v63, s46, v52 op_sel:[1,0,0,0]
    v_and_b32 v66, 0xffff, v62
    v_add_u32_sdwa v68, v56, v62 dst_sel:DWORD dst_unused:UNUSED_PAD src0_sel:DWORD src1_sel:WORD_0
    v_and_b32 v67, 0xffff, v63
    v_add_u32_sdwa v69, v56, v63 dst_sel:DWORD dst_unused:UNUSED_PAD src0_sel:DWORD src1_sel:WORD_0
    buffer_load_dwordx4 v64, s[28:31], s58 offen offset:0 lds
    buffer_load_dwordx4 v64, s[28:31], s59 offen offset:2080 lds
    buffer_load_dwordx4 v65, s[28:31], s60 offen offset:1024 lds
    buffer_load_dwordx4 v65, s[28:31], s61 offen offset:3104 lds
    ds_read_b64 v[70:71], v66 offset:40912
    ds_read_b64 v[72:73], v67 offset:40912
    ds_read_u16_d16_hi v74, v68 offset:40920
    ds_read_u16_d16_hi v76, v69 offset:40920
    s_branch M_join
L_again:
    s_setprio 0
    s_add_u32 s66, s66, 1
    s_cmp_gt_u32 s66, 0x8000
    s_cbranch_scc1 L_end
    s_cmp_eq_u32 s63, 0
    s_cselect_b32 s26, 32, 0
    s_add_u32 s62, s62, s26
    s_waitcnt vmcnt(0) lgkmcnt(0)
    s_barrier
    s_cmp_lg_u32 s44, 15
    s_cbranch_scc1 L_again2
    v_mov_b64 v[64:65], 0
    v_mov_b64 v[66:67], 0
    v_lshlrev_b32 v60, 4, v1
    v_mov_b32 v68, 0xffff0000
    v_mov_b32 v69, 0xffff0000
    v_mov_b32 v70, 0xffff0000
    v_mov_b32 v71, 0xffff0000
    ds_write_b128 v60, v[68:71] offset:16384
    ds_write_b128 v60, v[68:71] offset:17408
    ds_write_b128 v60, v[68:71] offset:18432
    ds_write_b128 v60, v[68:71] offset:19456
    ds_write_b128 v60, v[68:71] offset:20480
    ds_write_b128 v60, v[68:71] offset:21504
    ds_write_b128 v60, v[68:71] offset:22528
    ds_write_b128 v60, v[68:71] offset:23552
    ds_write_b128 v60, v[68:71] offset:24576
    ds_write_b128 v60, v[68:71] offset:25600
    ds_write_b128 v60, v[68:71] offset:26624
    ds_write_b128 v60, v[68:71] offset:27648
    ds_write_b128 v60, v[68:71] offset:28672
    ds_write_b128 v60, v[68:71] offset:29696
    ds_write_b128 v60, v[68:71] offset:30720
    ds_write_b128 v60, v[68:71] offset:31744
    ds_write_b128 v60, v[68:71] offset:32768
    ds_write_b128 v60, v[68:71] offset:33792
    ds_write_b128 v60, v[68:71] offset:34816
    ds_write_b128 v60, v[68:71] offset:35840
    ds_write_b128 v60, v[68:71] offset:36864
    ds_write_b128 v60, v[68:71] offset:37888
    ds_write_b128 v60, v[68:71] offset:38912
    s_bfm_b64 exec, 61, 0
    ds_write_b128 v60, v[68:71] offset:39936
    s_bfm_b64 exec, 42, 0
    v_mul_u32_u24 v61, 584, v1
    v_mul_u32_u24 v68, 43, v1
    v_lshrrev_b32 v68, 7, v68
    v_mad_i32_i24 v68, v68, -3, v1
    v_mul_u32_u24 v68, 56, v68
    v_add_u32 v68, 4294967224, v68
    v_sub_u32 v69, 4, v68
    ds_write_b64 v61, v[68:69] offset:16384
    s_mov_b64 exec, 1
    ds_write_b128 v60, v[64:67] offset:40912
    v_mov_b32 v70, 0
    v_mov_b32 v71, 1
    ds_write_b64 v60, v[70:71] offset:0
    s_mov_b64 exec, -1
    s_waitcnt lgkmcnt(0)
L_again2:
    s_lshr_b32 s26, s47, 4
    s_sub_u32 s27, s26, s44
    s_and_b32 s27, s27, 15
    v_and_or_b32 v97, v0, 48, s27
    s_lshl4_add_u32 s26, s26, s27
    s_lshl_b32 s26, s26, 8
    s_and_b32 s27, s47, 15
    s_add_u32 s26, s26, s27
    s_lshl_b32 s26, s26, 3
    s_add_u32 s26, s26, 14090240
    v_bfe_u32 v99, v0, 4, 2
    v_and_b32 v96, 3, v0
    v_lshl_add_u32 v99, v96, 2, v99
    v_lshl_add_u32 v99, v99, 7, s26
    s_mov_b32 s26, 55040
    v_mul_u32_u24 v97, s26, v97
    v_and_b32 v96, 15, v0
    v_add_u32 v96, s62, v96
    v_lshl_add_u32 v98, v96, 2, v97
    s_mov_b32 s72, 0xf000f000
    s_mov_b32 s65, 0
    s_barrier
    s_branch B_poll
L_last:
    s_endpgm
.section .rodata,"a"
.p2align 6
.amdhsa_kernel gather_scatter__tensor_product_equiv_mace__graph_kernel
  .amdhsa_next_free_vgpr 128
  .amdhsa_next_free_sgpr 78
  .amdhsa_accum_offset 128
  .amdhsa_group_segment_fixed_size 0
  .amdhsa_kernarg_size 88
  .amdhsa_user_sgpr_count 2
  .amdhsa_user_sgpr_kernarg_segment_ptr 1
  .amdhsa_system_sgpr_workgroup_id_x 1
  .amdhsa_float_denorm_mode_32 3
.end_amdhsa_kernel
.text
```
